```python
import torch

def _softmax(x, axis=-1):
    return torch.softmax(x, dim=axis)
def _gelu(x):
    return torch.nn.functional.gelu(x, approximate="tanh")
def _silu(x):
    return torch.nn.functional.silu(x)
def _sigmoid(x):
    return torch.sigmoid(x)
def _layernorm(x, axis=-1, eps=1e-5):
    m = x.mean(dim=axis, keepdim=True)
    v = x.var(dim=axis, keepdim=True, unbiased=False)
    return (x - m) / torch.sqrt(v + eps)
def _scatter_add(tgt, idx, src, axis=0):
    return tgt.clone().index_add_(axis, idx, src)
def _segment_sum(src, seg, n):
    out = torch.zeros((n,) + src.shape[1:], dtype=src.dtype)
    return out.index_add_(0, seg, src)
def _pad(x, pw):
    flat = tuple(v for pair in reversed(pw) for v in pair)
    return torch.nn.functional.pad(x, flat)

kernel_name = 'standalone__instancenorm__sampling'

def setup_inputs():

    _w = (lambda a: (lambda t: t.to(torch.bfloat16) if t.is_floating_point() else t)(torch.as_tensor(a)))
    B, C, H, W = 16, 640, 16, 32
    return {
        "x": _w(abs((lambda *s: torch.randn(*s, dtype=torch.bfloat16) * 0.05)(B, C, H, W))),
        "g": _w((lambda *s: torch.randn(*s, dtype=torch.bfloat16) * 0.05)(C) + 1.0),
        "b": _w((lambda *s: torch.randn(*s, dtype=torch.bfloat16) * 0.4)(C)),
    }

def reference(x, g, b):
    mu = x.mean(axis=(-2, -1), keepdims=True)
    var = ((x - mu) ** 2).mean(axis=(-2, -1), keepdims=True)
    xhat = (x - mu) / torch.sqrt(var + 1e-5)
    return xhat * g.reshape(1, -1, 1, 1) + b.reshape(1, -1, 1, 1)
```

```asm
; @launch grid=(256,1,1) block=(704,1,1) lds=2816
.amdgcn_target "amdgcn-amd-amdhsa--gfx950"
.text
.globl standalone__instancenorm__sampling_kernel
.p2align 8
.type standalone__instancenorm__sampling_kernel,@function
standalone__instancenorm__sampling_kernel:
    s_load_dwordx2 s[12:13], s[0:1], 0
    s_cmpk_ge_u32 s2, 256
    s_cbranch_scc1 L_end
    s_lshl_b32 s25, s2, 2
    v_and_b32 v3, 15, v0
    s_lshr_b32 s26, 0x88888de0, s25
    v_lshlrev_b32 v1, 6, v0
    s_mul_i32 s3, s2, 20
    v_mul_u32_u24 v3, 48, v3
    s_and_b32 s27, s26, 3
    s_and_b32 s26, s26, 12
    v_sub_u32 v1, v1, v3
    s_addk_i32 s26, 72
    s_lshl_b32 s26, s26, 9
    v_cmpx_gt_u32 vcc, s26, v1
    s_sub_u32 s3, s3, s27
    s_lshl_b32 s3, s3, 11
L_norm:
    s_lshl_b32 s14, 5, 21
    s_lshl_b32 s15, 1, 17
    s_cbranch_execz L_quit
    s_waitcnt lgkmcnt(0)
    buffer_load_dwordx4 v[8:11], v1, s[12:15], s3 offen nt
    buffer_load_dwordx4 v[12:15], v1, s[12:15], s3 offen offset:256 nt
    buffer_load_dwordx4 v[16:19], v1, s[12:15], s3 offen offset:512 nt
    buffer_load_dwordx4 v[20:23], v1, s[12:15], s3 offen offset:768 nt
    s_load_dwordx4 s[4:7], s[0:1], 8
    s_load_dwordx2 s[16:17], s[0:1], 24
    s_mov_b32 s18, s14
    s_mov_b32 s19, s15
    v_and_b32 v2, 0x30, v0
    v_lshrrev_b32 v4, 5, v0
    v_lshlrev_b32 v70, 2, v0
    v_readfirstlane_b32 s24, v4
    s_and_b32 s28, s2, 15
    s_mul_i32 s28, s28, 20
    s_cmp_eq_u32 exec_hi, 0
    s_cselect_b32 s30, 10, 20
    s_sub_u32 s28, s28, s27
    s_add_u32 s28, s28, s24
    s_lshl_b32 s28, s28, 2
    s_mov_b32 s29, 0xffff0000
    v_mov_b32 v72, 0
    v_and_b32 v71, 31, v0
    ds_write_b32 v70, v72
    v_sub_u32 v3, 10, v71
    v_min_u32 v71, 10, v71
    v_ashrrev_i32 v3, 31, v3
    v_mul_u32_u24 v71, 260, v71
    s_waitcnt lgkmcnt(0)
    v_mov_b32 v72, 1
    s_load_dwordx2 s[68:69], s[4:5], s28
    s_load_dwordx2 s[70:71], s[6:7], s28
    s_waitcnt vmcnt(3)
    ds_write_b32 v70, v72
    v_lshlrev_b32 v24, 16, v8
    v_and_b32 v25, s29, v8
    v_lshlrev_b32 v26, 16, v9
    v_and_b32 v27, s29, v9
    v_mov_b32_dpp v64, v24 row_newbcast:0 row_mask:0xf bank_mask:0xf
    v_lshlrev_b32 v28, 16, v10
    v_and_b32 v29, s29, v10
    v_lshlrev_b32 v30, 16, v11
    v_and_b32 v31, s29, v11
    v_pk_add_f32 v[24:25], v[24:25], v[64:65] op_sel_hi:[1,0] neg_lo:[0,1] neg_hi:[0,1]
    v_pk_add_f32 v[26:27], v[26:27], v[64:65] op_sel_hi:[1,0] neg_lo:[0,1] neg_hi:[0,1]
    v_pk_add_f32 v[28:29], v[28:29], v[64:65] op_sel_hi:[1,0] neg_lo:[0,1] neg_hi:[0,1]
    v_pk_add_f32 v[30:31], v[30:31], v[64:65] op_sel_hi:[1,0] neg_lo:[0,1] neg_hi:[0,1]
    v_pk_add_f32 v[56:57], v[24:25], v[26:27]
    v_pk_mul_f32 v[60:61], v[24:25], v[24:25]
    v_pk_add_f32 v[58:59], v[28:29], v[30:31]
    v_pk_mul_f32 v[62:63], v[26:27], v[26:27]
    v_pk_fma_f32 v[60:61], v[28:29], v[28:29], v[60:61]
    v_pk_fma_f32 v[62:63], v[30:31], v[30:31], v[62:63]
    s_waitcnt vmcnt(2)
    v_lshlrev_b32 v32, 16, v12
    v_and_b32 v33, s29, v12
    v_lshlrev_b32 v34, 16, v13
    v_and_b32 v35, s29, v13
    v_lshlrev_b32 v36, 16, v14
    v_and_b32 v37, s29, v14
    v_lshlrev_b32 v38, 16, v15
    v_and_b32 v39, s29, v15
    v_pk_add_f32 v[32:33], v[32:33], v[64:65] op_sel_hi:[1,0] neg_lo:[0,1] neg_hi:[0,1]
    v_pk_add_f32 v[34:35], v[34:35], v[64:65] op_sel_hi:[1,0] neg_lo:[0,1] neg_hi:[0,1]
    v_pk_add_f32 v[36:37], v[36:37], v[64:65] op_sel_hi:[1,0] neg_lo:[0,1] neg_hi:[0,1]
    v_pk_add_f32 v[38:39], v[38:39], v[64:65] op_sel_hi:[1,0] neg_lo:[0,1] neg_hi:[0,1]
    v_pk_add_f32 v[56:57], v[56:57], v[32:33]
    v_pk_fma_f32 v[60:61], v[32:33], v[32:33], v[60:61]
    v_pk_add_f32 v[58:59], v[58:59], v[34:35]
    v_pk_fma_f32 v[62:63], v[34:35], v[34:35], v[62:63]
    v_pk_add_f32 v[56:57], v[56:57], v[36:37]
    v_pk_fma_f32 v[60:61], v[36:37], v[36:37], v[60:61]
    v_pk_add_f32 v[58:59], v[58:59], v[38:39]
    v_pk_fma_f32 v[62:63], v[38:39], v[38:39], v[62:63]
    s_waitcnt vmcnt(1)
    v_lshlrev_b32 v40, 16, v16
    v_and_b32 v41, s29, v16
    v_lshlrev_b32 v42, 16, v17
    v_and_b32 v43, s29, v17
    v_lshlrev_b32 v44, 16, v18
    v_and_b32 v45, s29, v18
    v_lshlrev_b32 v46, 16, v19
    v_and_b32 v47, s29, v19
    v_pk_add_f32 v[40:41], v[40:41], v[64:65] op_sel_hi:[1,0] neg_lo:[0,1] neg_hi:[0,1]
    v_pk_add_f32 v[42:43], v[42:43], v[64:65] op_sel_hi:[1,0] neg_lo:[0,1] neg_hi:[0,1]
    v_pk_add_f32 v[44:45], v[44:45], v[64:65] op_sel_hi:[1,0] neg_lo:[0,1] neg_hi:[0,1]
    v_pk_add_f32 v[46:47], v[46:47], v[64:65] op_sel_hi:[1,0] neg_lo:[0,1] neg_hi:[0,1]
    v_pk_add_f32 v[56:57], v[56:57], v[40:41]
    v_pk_fma_f32 v[60:61], v[40:41], v[40:41], v[60:61]
    v_pk_add_f32 v[58:59], v[58:59], v[42:43]
    v_pk_fma_f32 v[62:63], v[42:43], v[42:43], v[62:63]
    v_pk_add_f32 v[56:57], v[56:57], v[44:45]
    v_pk_fma_f32 v[60:61], v[44:45], v[44:45], v[60:61]
    v_pk_add_f32 v[58:59], v[58:59], v[46:47]
    v_pk_fma_f32 v[62:63], v[46:47], v[46:47], v[62:63]
    s_waitcnt vmcnt(0)
    v_lshlrev_b32 v48, 16, v20
    v_and_b32 v49, s29, v20
    v_lshlrev_b32 v50, 16, v21
    v_and_b32 v51, s29, v21
    v_lshlrev_b32 v52, 16, v22
    v_and_b32 v53, s29, v22
    v_lshlrev_b32 v54, 16, v23
    v_and_b32 v55, s29, v23
    v_pk_add_f32 v[48:49], v[48:49], v[64:65] op_sel_hi:[1,0] neg_lo:[0,1] neg_hi:[0,1]
    v_pk_add_f32 v[50:51], v[50:51], v[64:65] op_sel_hi:[1,0] neg_lo:[0,1] neg_hi:[0,1]
    v_pk_add_f32 v[52:53], v[52:53], v[64:65] op_sel_hi:[1,0] neg_lo:[0,1] neg_hi:[0,1]
    v_pk_add_f32 v[54:55], v[54:55], v[64:65] op_sel_hi:[1,0] neg_lo:[0,1] neg_hi:[0,1]
    v_pk_add_f32 v[56:57], v[56:57], v[48:49]
    v_pk_fma_f32 v[60:61], v[48:49], v[48:49], v[60:61]
    v_pk_add_f32 v[58:59], v[58:59], v[50:51]
    v_pk_fma_f32 v[62:63], v[50:51], v[50:51], v[62:63]
    v_pk_add_f32 v[56:57], v[56:57], v[52:53]
    v_pk_fma_f32 v[60:61], v[52:53], v[52:53], v[60:61]
    v_pk_add_f32 v[58:59], v[58:59], v[54:55]
    v_pk_fma_f32 v[62:63], v[54:55], v[54:55], v[62:63]
    ds_read_b32 v72, v71
    v_pk_add_f32 v[56:57], v[56:57], v[58:59]
    v_pk_add_f32 v[60:61], v[60:61], v[62:63]
    v_add_f32 v56, v56, v57
    v_add_f32 v60, v60, v61
    v_mov_b32 v68, 0x3727c5ac
    v_add_f32_dpp v57, v56, v56 row_ror:8 row_mask:0xf bank_mask:0xf
    v_add_f32_dpp v61, v60, v60 row_ror:8 row_mask:0xf bank_mask:0xf
    s_nop 0
    v_add_f32_dpp v56, v57, v57 row_ror:4 row_mask:0xf bank_mask:0xf
    v_add_f32_dpp v60, v61, v61 row_ror:4 row_mask:0xf bank_mask:0xf
    s_nop 0
    v_add_f32_dpp v57, v56, v56 row_ror:2 row_mask:0xf bank_mask:0xf
    v_add_f32_dpp v61, v60, v60 row_ror:2 row_mask:0xf bank_mask:0xf
    s_nop 0
    v_add_f32_dpp v56, v57, v57 row_ror:1 row_mask:0xf bank_mask:0xf
    v_add_f32_dpp v60, v61, v61 row_ror:1 row_mask:0xf bank_mask:0xf
    v_mul_f32 v64, 0x3b000000, v56
    v_fmac_f32 v68, 0x3b000000, v60
    v_fma_f32 v68, -v64, v64, v68
    v_max_f32 v68, 0x3727c5ac, v68
    v_rsq_f32 v68, v68
    s_waitcnt lgkmcnt(0)
    v_lshrrev_b64 v[4:5], v2, s[68:69]
    v_lshrrev_b64 v[6:7], v2, s[70:71]
    v_lshlrev_b32 v4, 16, v4
    v_lshlrev_b32 v5, 16, v6
    v_mul_f32 v66, v68, v4
    v_fma_f32 v5, -v64, v66, v5
    v_cmp_lt_u32 vcc, v3, v72
    s_bcnt1_i32_b64 s26, vcc
    s_cmp_lt_u32 s26, s30
    v_pk_fma_f32 v[24:25], v[24:25], v[66:67], v[4:5] op_sel:[0,0,1] op_sel_hi:[1,0,1]
    v_pk_fma_f32 v[26:27], v[26:27], v[66:67], v[4:5] op_sel:[0,0,1] op_sel_hi:[1,0,1]
    v_pk_fma_f32 v[28:29], v[28:29], v[66:67], v[4:5] op_sel:[0,0,1] op_sel_hi:[1,0,1]
    v_pk_fma_f32 v[30:31], v[30:31], v[66:67], v[4:5] op_sel:[0,0,1] op_sel_hi:[1,0,1]
    v_cvt_pk_bf16_f32 v8, v24, v25
    v_cvt_pk_bf16_f32 v9, v26, v27
    v_cvt_pk_bf16_f32 v10, v28, v29
    v_cvt_pk_bf16_f32 v11, v30, v31
    s_cbranch_scc1 L_e0
    buffer_store_dwordx4 v[8:11], v1, s[16:19], s3 offen sc0 sc1
L_e0:
    v_pk_fma_f32 v[32:33], v[32:33], v[66:67], v[4:5] op_sel:[0,0,1] op_sel_hi:[1,0,1]
    v_pk_fma_f32 v[34:35], v[34:35], v[66:67], v[4:5] op_sel:[0,0,1] op_sel_hi:[1,0,1]
    v_pk_fma_f32 v[36:37], v[36:37], v[66:67], v[4:5] op_sel:[0,0,1] op_sel_hi:[1,0,1]
    v_pk_fma_f32 v[38:39], v[38:39], v[66:67], v[4:5] op_sel:[0,0,1] op_sel_hi:[1,0,1]
    v_cvt_pk_bf16_f32 v12, v32, v33
    v_cvt_pk_bf16_f32 v13, v34, v35
    v_cvt_pk_bf16_f32 v14, v36, v37
    v_cvt_pk_bf16_f32 v15, v38, v39
    s_cbranch_scc1 L_e1
    buffer_store_dwordx4 v[12:15], v1, s[16:19], s3 offen offset:256 sc0 sc1
L_e1:
    v_pk_fma_f32 v[40:41], v[40:41], v[66:67], v[4:5] op_sel:[0,0,1] op_sel_hi:[1,0,1]
    v_pk_fma_f32 v[42:43], v[42:43], v[66:67], v[4:5] op_sel:[0,0,1] op_sel_hi:[1,0,1]
    v_pk_fma_f32 v[44:45], v[44:45], v[66:67], v[4:5] op_sel:[0,0,1] op_sel_hi:[1,0,1]
    v_pk_fma_f32 v[46:47], v[46:47], v[66:67], v[4:5] op_sel:[0,0,1] op_sel_hi:[1,0,1]
    v_cvt_pk_bf16_f32 v16, v40, v41
    v_cvt_pk_bf16_f32 v17, v42, v43
    v_cvt_pk_bf16_f32 v18, v44, v45
    v_cvt_pk_bf16_f32 v19, v46, v47
    s_cbranch_scc1 L_e2
    buffer_store_dwordx4 v[16:19], v1, s[16:19], s3 offen offset:512 sc0 sc1
L_e2:
    v_pk_fma_f32 v[48:49], v[48:49], v[66:67], v[4:5] op_sel:[0,0,1] op_sel_hi:[1,0,1]
    v_pk_fma_f32 v[50:51], v[50:51], v[66:67], v[4:5] op_sel:[0,0,1] op_sel_hi:[1,0,1]
    v_pk_fma_f32 v[52:53], v[52:53], v[66:67], v[4:5] op_sel:[0,0,1] op_sel_hi:[1,0,1]
    v_pk_fma_f32 v[54:55], v[54:55], v[66:67], v[4:5] op_sel:[0,0,1] op_sel_hi:[1,0,1]
    v_cvt_pk_bf16_f32 v20, v48, v49
    v_cvt_pk_bf16_f32 v21, v50, v51
    v_cvt_pk_bf16_f32 v22, v52, v53
    v_cvt_pk_bf16_f32 v23, v54, v55
    s_cbranch_scc0 L_last
L_gate:
    ds_read_b32 v72, v71
    s_waitcnt lgkmcnt(0)
    v_cmp_lt_u32 vcc, v3, v72
    s_bcnt1_i32_b64 s26, vcc
    s_cmp_lt_u32 s26, s30
    s_cbranch_scc1 L_gate
    buffer_store_dwordx4 v[8:11], v1, s[16:19], s3 offen sc0 sc1
    buffer_store_dwordx4 v[12:15], v1, s[16:19], s3 offen offset:256 sc0 sc1
    buffer_store_dwordx4 v[16:19], v1, s[16:19], s3 offen offset:512 sc0 sc1
L_last:
    buffer_store_dwordx4 v[20:23], v1, s[16:19], s3 offen offset:768 sc0 sc1
L_end:
    s_endpgm
L_quit:
    s_mov_b64 exec, -1
    v_lshlrev_b32 v70, 2, v0
    v_mov_b32 v72, 1
    ds_write_b32 v70, v72
    s_waitcnt lgkmcnt(0)
    s_endpgm
.section .rodata,"a"
.p2align 6
.amdhsa_kernel standalone__instancenorm__sampling_kernel
  .amdhsa_next_free_vgpr 73
  .amdhsa_next_free_sgpr 96
  .amdhsa_accum_offset 76
  .amdhsa_group_segment_fixed_size 0
  .amdhsa_kernarg_size 48
  .amdhsa_user_sgpr_count 2
  .amdhsa_user_sgpr_kernarg_segment_ptr 1
  .amdhsa_system_sgpr_workgroup_id_x 1
  .amdhsa_float_denorm_mode_32 3
.end_amdhsa_kernel
```
